```python
import torch

def _softmax(x, axis=-1):
    return torch.softmax(x, dim=axis)
def _gelu(x):
    return torch.nn.functional.gelu(x, approximate="tanh")
def _silu(x):
    return torch.nn.functional.silu(x)
def _sigmoid(x):
    return torch.sigmoid(x)
def _layernorm(x, axis=-1, eps=1e-5):
    m = x.mean(dim=axis, keepdim=True)
    v = x.var(dim=axis, keepdim=True, unbiased=False)
    return (x - m) / torch.sqrt(v + eps)
def _scatter_add(tgt, idx, src, axis=0):
    return tgt.clone().index_add_(axis, idx, src)
def _segment_sum(src, seg, n):
    out = torch.zeros((n,) + src.shape[1:], dtype=src.dtype)
    return out.index_add_(0, seg, src)
def _pad(x, pw):
    flat = tuple(v for pair in reversed(pw) for v in pair)
    return torch.nn.functional.pad(x, flat)

kernel_name = 'standalone__grn__sampling'

def setup_inputs():

    _w = (lambda a: (lambda t: t.to(torch.bfloat16) if t.is_floating_point() else t)(torch.as_tensor(a)))
    B, S, D = 1024, 16, 1024
    return {
        "x": _w((lambda *s: torch.randn(*s, dtype=torch.bfloat16) * 0.05)(B, S, D)),
        "g": _w((lambda *s: torch.randn(*s, dtype=torch.bfloat16) * 0.4)(D) * 0.1),
        "b": _w((lambda *s: torch.randn(*s, dtype=torch.bfloat16) * 0.1)(D) * 0.1),
    }

def reference(x, g, b):
    gx = torch.sqrt((x * x).sum(axis=-2, keepdims=True))
    nx = gx / (gx.mean(axis=-1, keepdims=True) + 1e-6)
    return g * (x * nx) + b + x
```

```asm
; @launch grid=(1024,1,1) block=(256,1,1) lds=16
.amdgcn_target "amdgcn-amd-amdhsa--gfx950"
.text
.globl standalone__grn__sampling_kernel
.p2align 12
.p2align 8
.type standalone__grn__sampling_kernel,@function
standalone__grn__sampling_kernel:
    s_load_dwordx2 s[12:13], s[0:1], 0
    s_load_dwordx4 s[4:7], s[0:1], 8
    s_load_dwordx2 s[16:17], s[0:1], 24
    s_setprio 3
    s_cmp_ge_u32 s2, 1024
    s_cbranch_scc1 L_end
    s_and_b32 s3, s2, 7
    s_lshl_b32 s3, s3, 5
    s_bfe_u32 s22, s2, 0x50003
    s_or_b32 s3, s3, s22
    s_and_b32 s22, s2, 0x300
    s_or_b32 s3, s3, s22
    s_lshl_b32 s3, s3, 15
    v_and_b32 v1, 31, v0
    v_lshlrev_b32 v1, 4, v1
    v_lshrrev_b32 v2, 6, v0
    v_lshl_add_u32 v1, v2, 9, v1
    v_bfe_u32 v3, v0, 5, 1
    v_lshl_add_u32 v4, v3, 11, v1
    v_add_u32 v4, s3, v4
    v_lshl_add_u32 v5, v3, 3, v1
    v_lshlrev_b32 v6, 2, v2
    v_mov_b32 v7, 0
    s_movk_i32 s25, 0x1000
    s_movk_i32 s26, 0x2000
    s_movk_i32 s27, 0x3000
    s_movk_i32 s28, 0x4000
    s_movk_i32 s29, 0x5000
    s_movk_i32 s30, 0x6000
    s_movk_i32 s31, 0x7000
    s_mov_b32 s14, 0x2000000
    s_mov_b32 s15, 0x20000
    s_mov_b32 s18, 0x2000000
    s_mov_b32 s19, 0x20000
    s_mov_b32 s20, 0xffff0000
    s_mov_b32 s21, 0x3a800000
    s_waitcnt lgkmcnt(0)
    buffer_load_dwordx4 v[16:19], v4, s[12:15], 0 offen nt
    buffer_load_dwordx4 v[20:23], v4, s[12:15], s25 offen nt
    buffer_load_dwordx4 v[24:27], v4, s[12:15], s26 offen nt
    buffer_load_dwordx4 v[28:31], v4, s[12:15], s27 offen nt
    buffer_load_dwordx4 v[32:35], v4, s[12:15], s28 offen nt
    buffer_load_dwordx4 v[36:39], v4, s[12:15], s29 offen nt
    buffer_load_dwordx4 v[40:43], v4, s[12:15], s30 offen nt
    buffer_load_dwordx4 v[44:47], v4, s[12:15], s31 offen nt
    global_load_dwordx2 v[8:9], v5, s[4:5]
    global_load_dwordx4 v[12:15], v1, s[6:7]
    s_setprio 0
    s_waitcnt vmcnt(9)
    v_lshlrev_b32 v48, 16, v16
    v_lshlrev_b32 v49, 16, v17
    v_lshlrev_b32 v50, 16, v18
    v_lshlrev_b32 v51, 16, v19
    v_and_b32 v16, s20, v16
    v_and_b32 v17, s20, v17
    v_and_b32 v18, s20, v18
    v_and_b32 v19, s20, v19
    v_pk_mul_f32 v[80:81], v[48:49], v[48:49]
    v_pk_mul_f32 v[82:83], v[50:51], v[50:51]
    v_pk_mul_f32 v[84:85], v[16:17], v[16:17]
    v_pk_mul_f32 v[86:87], v[18:19], v[18:19]
    s_waitcnt vmcnt(8)
    v_lshlrev_b32 v52, 16, v20
    v_lshlrev_b32 v53, 16, v21
    v_lshlrev_b32 v54, 16, v22
    v_lshlrev_b32 v55, 16, v23
    v_and_b32 v20, s20, v20
    v_and_b32 v21, s20, v21
    v_and_b32 v22, s20, v22
    v_and_b32 v23, s20, v23
    v_pk_fma_f32 v[80:81], v[52:53], v[52:53], v[80:81]
    v_pk_fma_f32 v[82:83], v[54:55], v[54:55], v[82:83]
    v_pk_fma_f32 v[84:85], v[20:21], v[20:21], v[84:85]
    v_pk_fma_f32 v[86:87], v[22:23], v[22:23], v[86:87]
    s_waitcnt vmcnt(7)
    v_lshlrev_b32 v56, 16, v24
    v_lshlrev_b32 v57, 16, v25
    v_lshlrev_b32 v58, 16, v26
    v_lshlrev_b32 v59, 16, v27
    v_and_b32 v24, s20, v24
    v_and_b32 v25, s20, v25
    v_and_b32 v26, s20, v26
    v_and_b32 v27, s20, v27
    v_pk_fma_f32 v[80:81], v[56:57], v[56:57], v[80:81]
    v_pk_fma_f32 v[82:83], v[58:59], v[58:59], v[82:83]
    v_pk_fma_f32 v[84:85], v[24:25], v[24:25], v[84:85]
    v_pk_fma_f32 v[86:87], v[26:27], v[26:27], v[86:87]
    s_waitcnt vmcnt(6)
    v_lshlrev_b32 v60, 16, v28
    v_lshlrev_b32 v61, 16, v29
    v_lshlrev_b32 v62, 16, v30
    v_lshlrev_b32 v63, 16, v31
    v_and_b32 v28, s20, v28
    v_and_b32 v29, s20, v29
    v_and_b32 v30, s20, v30
    v_and_b32 v31, s20, v31
    v_pk_fma_f32 v[80:81], v[60:61], v[60:61], v[80:81]
    v_pk_fma_f32 v[82:83], v[62:63], v[62:63], v[82:83]
    v_pk_fma_f32 v[84:85], v[28:29], v[28:29], v[84:85]
    v_pk_fma_f32 v[86:87], v[30:31], v[30:31], v[86:87]
    s_waitcnt vmcnt(5)
    v_lshlrev_b32 v64, 16, v32
    v_lshlrev_b32 v65, 16, v33
    v_lshlrev_b32 v66, 16, v34
    v_lshlrev_b32 v67, 16, v35
    v_and_b32 v32, s20, v32
    v_and_b32 v33, s20, v33
    v_and_b32 v34, s20, v34
    v_and_b32 v35, s20, v35
    v_pk_fma_f32 v[80:81], v[64:65], v[64:65], v[80:81]
    v_pk_fma_f32 v[82:83], v[66:67], v[66:67], v[82:83]
    v_pk_fma_f32 v[84:85], v[32:33], v[32:33], v[84:85]
    v_pk_fma_f32 v[86:87], v[34:35], v[34:35], v[86:87]
    s_waitcnt vmcnt(4)
    v_lshlrev_b32 v68, 16, v36
    v_lshlrev_b32 v69, 16, v37
    v_lshlrev_b32 v70, 16, v38
    v_lshlrev_b32 v71, 16, v39
    v_and_b32 v36, s20, v36
    v_and_b32 v37, s20, v37
    v_and_b32 v38, s20, v38
    v_and_b32 v39, s20, v39
    v_pk_fma_f32 v[80:81], v[68:69], v[68:69], v[80:81]
    v_pk_fma_f32 v[82:83], v[70:71], v[70:71], v[82:83]
    v_pk_fma_f32 v[84:85], v[36:37], v[36:37], v[84:85]
    v_pk_fma_f32 v[86:87], v[38:39], v[38:39], v[86:87]
    s_waitcnt vmcnt(3)
    v_lshlrev_b32 v72, 16, v40
    v_lshlrev_b32 v73, 16, v41
    v_lshlrev_b32 v74, 16, v42
    v_lshlrev_b32 v75, 16, v43
    v_and_b32 v40, s20, v40
    v_and_b32 v41, s20, v41
    v_and_b32 v42, s20, v42
    v_and_b32 v43, s20, v43
    v_pk_fma_f32 v[80:81], v[72:73], v[72:73], v[80:81]
    v_pk_fma_f32 v[82:83], v[74:75], v[74:75], v[82:83]
    v_pk_fma_f32 v[84:85], v[40:41], v[40:41], v[84:85]
    v_pk_fma_f32 v[86:87], v[42:43], v[42:43], v[86:87]
    s_waitcnt vmcnt(2)
    v_lshlrev_b32 v76, 16, v44
    v_lshlrev_b32 v77, 16, v45
    v_lshlrev_b32 v78, 16, v46
    v_lshlrev_b32 v79, 16, v47
    v_and_b32 v44, s20, v44
    v_and_b32 v45, s20, v45
    v_and_b32 v46, s20, v46
    v_and_b32 v47, s20, v47
    v_pk_fma_f32 v[80:81], v[76:77], v[76:77], v[80:81]
    v_pk_fma_f32 v[82:83], v[78:79], v[78:79], v[82:83]
    v_pk_fma_f32 v[84:85], v[44:45], v[44:45], v[84:85]
    v_pk_fma_f32 v[86:87], v[46:47], v[46:47], v[86:87]
    s_nop 1
    v_permlane32_swap_b32 v80, v82
    v_permlane32_swap_b32 v81, v83
    v_permlane32_swap_b32 v84, v86
    v_permlane32_swap_b32 v85, v87
    v_pk_add_f32 v[80:81], v[80:81], v[82:83]
    v_pk_add_f32 v[84:85], v[84:85], v[86:87]
    v_sqrt_f32 v80, v80
    v_sqrt_f32 v81, v81
    v_sqrt_f32 v84, v84
    v_sqrt_f32 v85, v85
    s_nop 0
    v_pk_add_f32 v[2:3], v[80:81], v[84:85]
    v_add_f32 v2, v2, v3
    s_nop 1
    v_add_f32_dpp v2, v2, v2 quad_perm:[1,0,3,2] row_mask:0xf bank_mask:0xf
    s_nop 1
    v_add_f32_dpp v2, v2, v2 quad_perm:[2,3,0,1] row_mask:0xf bank_mask:0xf
    s_nop 1
    v_add_f32_dpp v2, v2, v2 row_half_mirror row_mask:0xf bank_mask:0xf
    s_nop 1
    v_add_f32_dpp v2, v2, v2 row_mirror row_mask:0xf bank_mask:0xf
    s_nop 1
    v_add_f32_dpp v2, v2, v2 row_bcast:15 row_mask:0xa bank_mask:0xf
    s_nop 1
    v_add_f32_dpp v2, v2, v2 row_bcast:31 row_mask:0xc bank_mask:0xf
    s_mov_b32 exec_lo, 0
    s_mov_b32 exec_hi, 0x80000000
    ds_write_b32 v6, v2
    s_mov_b64 exec, -1
    s_waitcnt vmcnt(0)
    v_lshlrev_b32 v10, 16, v8
    v_lshlrev_b32 v11, 16, v9
    v_and_b32 v8, s20, v8
    v_and_b32 v9, s20, v9
    v_pk_mul_f32 v[80:81], v[80:81], v[10:11]
    v_pk_mul_f32 v[84:85], v[84:85], v[8:9]
    v_lshlrev_b32 v88, 16, v12
    v_lshlrev_b32 v89, 16, v13
    v_lshlrev_b32 v90, 16, v14
    v_lshlrev_b32 v91, 16, v15
    v_and_b32 v12, s20, v12
    v_and_b32 v13, s20, v13
    v_and_b32 v14, s20, v14
    v_and_b32 v15, s20, v15
    v_mov_b32 v3, 0x358637bd
    s_waitcnt lgkmcnt(0)
    s_barrier
    ds_read_b128 v[8:11], v7
    s_waitcnt lgkmcnt(0)
    v_pk_add_f32 v[8:9], v[8:9], v[10:11]
    v_add_f32 v2, v8, v9
    v_fma_f32 v2, v2, s21, v3
    v_rcp_f32 v2, v2
    s_nop 0
    v_mul_f32 v80, v80, v2
    v_mul_f32 v81, v81, v2
    v_mul_f32 v84, v84, v2
    v_mul_f32 v85, v85, v2
    v_mov_b32 v82, v80
    v_mov_b32 v83, v81
    v_mov_b32 v86, v84
    v_mov_b32 v87, v85
    s_nop 1
    v_permlane32_swap_b32 v80, v82
    v_permlane32_swap_b32 v81, v83
    v_permlane32_swap_b32 v84, v86
    v_permlane32_swap_b32 v85, v87
    v_pk_fma_f32 v[92:93], v[48:49], v[80:81], v[88:89]
    v_pk_fma_f32 v[94:95], v[50:51], v[82:83], v[90:91]
    v_pk_fma_f32 v[96:97], v[16:17], v[84:85], v[12:13]
    v_pk_fma_f32 v[98:99], v[18:19], v[86:87], v[14:15]
    v_cvt_pk_bf16_f32 v96, v92, v96
    v_cvt_pk_bf16_f32 v97, v93, v97
    v_cvt_pk_bf16_f32 v98, v94, v98
    v_cvt_pk_bf16_f32 v99, v95, v99
    v_lshlrev_b32 v92, 16, v96
    v_lshlrev_b32 v93, 16, v97
    v_lshlrev_b32 v94, 16, v98
    v_lshlrev_b32 v95, 16, v99
    v_and_b32 v96, s20, v96
    v_and_b32 v97, s20, v97
    v_and_b32 v98, s20, v98
    v_and_b32 v99, s20, v99
    v_pk_add_f32 v[48:49], v[48:49], v[92:93]
    v_pk_add_f32 v[50:51], v[50:51], v[94:95]
    v_pk_add_f32 v[16:17], v[16:17], v[96:97]
    v_pk_add_f32 v[18:19], v[18:19], v[98:99]
    v_cvt_pk_bf16_f32 v16, v48, v16
    v_cvt_pk_bf16_f32 v17, v49, v17
    v_cvt_pk_bf16_f32 v18, v50, v18
    v_cvt_pk_bf16_f32 v19, v51, v19
    v_pk_fma_f32 v[92:93], v[52:53], v[80:81], v[88:89]
    v_pk_fma_f32 v[94:95], v[54:55], v[82:83], v[90:91]
    v_pk_fma_f32 v[96:97], v[20:21], v[84:85], v[12:13]
    v_pk_fma_f32 v[98:99], v[22:23], v[86:87], v[14:15]
    v_cvt_pk_bf16_f32 v96, v92, v96
    v_cvt_pk_bf16_f32 v97, v93, v97
    v_cvt_pk_bf16_f32 v98, v94, v98
    v_cvt_pk_bf16_f32 v99, v95, v99
    v_lshlrev_b32 v92, 16, v96
    v_lshlrev_b32 v93, 16, v97
    v_lshlrev_b32 v94, 16, v98
    v_lshlrev_b32 v95, 16, v99
    v_and_b32 v96, s20, v96
    v_and_b32 v97, s20, v97
    v_and_b32 v98, s20, v98
    v_and_b32 v99, s20, v99
    v_pk_add_f32 v[52:53], v[52:53], v[92:93]
    v_pk_add_f32 v[54:55], v[54:55], v[94:95]
    v_pk_add_f32 v[20:21], v[20:21], v[96:97]
    v_pk_add_f32 v[22:23], v[22:23], v[98:99]
    v_cvt_pk_bf16_f32 v20, v52, v20
    v_cvt_pk_bf16_f32 v21, v53, v21
    v_cvt_pk_bf16_f32 v22, v54, v22
    v_cvt_pk_bf16_f32 v23, v55, v23
    v_pk_fma_f32 v[92:93], v[56:57], v[80:81], v[88:89]
    v_pk_fma_f32 v[94:95], v[58:59], v[82:83], v[90:91]
    v_pk_fma_f32 v[96:97], v[24:25], v[84:85], v[12:13]
    v_pk_fma_f32 v[98:99], v[26:27], v[86:87], v[14:15]
    v_cvt_pk_bf16_f32 v96, v92, v96
    v_cvt_pk_bf16_f32 v97, v93, v97
    v_cvt_pk_bf16_f32 v98, v94, v98
    v_cvt_pk_bf16_f32 v99, v95, v99
    v_lshlrev_b32 v92, 16, v96
    v_lshlrev_b32 v93, 16, v97
    v_lshlrev_b32 v94, 16, v98
    v_lshlrev_b32 v95, 16, v99
    v_and_b32 v96, s20, v96
    v_and_b32 v97, s20, v97
    v_and_b32 v98, s20, v98
    v_and_b32 v99, s20, v99
    v_pk_add_f32 v[56:57], v[56:57], v[92:93]
    v_pk_add_f32 v[58:59], v[58:59], v[94:95]
    v_pk_add_f32 v[24:25], v[24:25], v[96:97]
    v_pk_add_f32 v[26:27], v[26:27], v[98:99]
    v_cvt_pk_bf16_f32 v24, v56, v24
    v_cvt_pk_bf16_f32 v25, v57, v25
    v_cvt_pk_bf16_f32 v26, v58, v26
    v_cvt_pk_bf16_f32 v27, v59, v27
    v_pk_fma_f32 v[92:93], v[60:61], v[80:81], v[88:89]
    v_pk_fma_f32 v[94:95], v[62:63], v[82:83], v[90:91]
    v_pk_fma_f32 v[96:97], v[28:29], v[84:85], v[12:13]
    v_pk_fma_f32 v[98:99], v[30:31], v[86:87], v[14:15]
    v_cvt_pk_bf16_f32 v96, v92, v96
    v_cvt_pk_bf16_f32 v97, v93, v97
    v_cvt_pk_bf16_f32 v98, v94, v98
    v_cvt_pk_bf16_f32 v99, v95, v99
    v_lshlrev_b32 v92, 16, v96
    v_lshlrev_b32 v93, 16, v97
    v_lshlrev_b32 v94, 16, v98
    v_lshlrev_b32 v95, 16, v99
    v_and_b32 v96, s20, v96
    v_and_b32 v97, s20, v97
    v_and_b32 v98, s20, v98
    v_and_b32 v99, s20, v99
    v_pk_add_f32 v[60:61], v[60:61], v[92:93]
    v_pk_add_f32 v[62:63], v[62:63], v[94:95]
    v_pk_add_f32 v[28:29], v[28:29], v[96:97]
    v_pk_add_f32 v[30:31], v[30:31], v[98:99]
    v_cvt_pk_bf16_f32 v28, v60, v28
    v_cvt_pk_bf16_f32 v29, v61, v29
    v_cvt_pk_bf16_f32 v30, v62, v30
    v_cvt_pk_bf16_f32 v31, v63, v31
    v_pk_fma_f32 v[92:93], v[64:65], v[80:81], v[88:89]
    v_pk_fma_f32 v[94:95], v[66:67], v[82:83], v[90:91]
    v_pk_fma_f32 v[96:97], v[32:33], v[84:85], v[12:13]
    v_pk_fma_f32 v[98:99], v[34:35], v[86:87], v[14:15]
    v_cvt_pk_bf16_f32 v96, v92, v96
    v_cvt_pk_bf16_f32 v97, v93, v97
    v_cvt_pk_bf16_f32 v98, v94, v98
    v_cvt_pk_bf16_f32 v99, v95, v99
    v_lshlrev_b32 v92, 16, v96
    v_lshlrev_b32 v93, 16, v97
    v_lshlrev_b32 v94, 16, v98
    v_lshlrev_b32 v95, 16, v99
    v_and_b32 v96, s20, v96
    v_and_b32 v97, s20, v97
    v_and_b32 v98, s20, v98
    v_and_b32 v99, s20, v99
    v_pk_add_f32 v[64:65], v[64:65], v[92:93]
    v_pk_add_f32 v[66:67], v[66:67], v[94:95]
    v_pk_add_f32 v[32:33], v[32:33], v[96:97]
    v_pk_add_f32 v[34:35], v[34:35], v[98:99]
    v_cvt_pk_bf16_f32 v32, v64, v32
    v_cvt_pk_bf16_f32 v33, v65, v33
    v_cvt_pk_bf16_f32 v34, v66, v34
    v_cvt_pk_bf16_f32 v35, v67, v35
    v_pk_fma_f32 v[92:93], v[68:69], v[80:81], v[88:89]
    v_pk_fma_f32 v[94:95], v[70:71], v[82:83], v[90:91]
    v_pk_fma_f32 v[96:97], v[36:37], v[84:85], v[12:13]
    v_pk_fma_f32 v[98:99], v[38:39], v[86:87], v[14:15]
    v_cvt_pk_bf16_f32 v96, v92, v96
    v_cvt_pk_bf16_f32 v97, v93, v97
    v_cvt_pk_bf16_f32 v98, v94, v98
    v_cvt_pk_bf16_f32 v99, v95, v99
    v_lshlrev_b32 v92, 16, v96
    v_lshlrev_b32 v93, 16, v97
    v_lshlrev_b32 v94, 16, v98
    v_lshlrev_b32 v95, 16, v99
    v_and_b32 v96, s20, v96
    v_and_b32 v97, s20, v97
    v_and_b32 v98, s20, v98
    v_and_b32 v99, s20, v99
    v_pk_add_f32 v[68:69], v[68:69], v[92:93]
    v_pk_add_f32 v[70:71], v[70:71], v[94:95]
    v_pk_add_f32 v[36:37], v[36:37], v[96:97]
    v_pk_add_f32 v[38:39], v[38:39], v[98:99]
    v_cvt_pk_bf16_f32 v36, v68, v36
    v_cvt_pk_bf16_f32 v37, v69, v37
    v_cvt_pk_bf16_f32 v38, v70, v38
    v_cvt_pk_bf16_f32 v39, v71, v39
    v_pk_fma_f32 v[92:93], v[72:73], v[80:81], v[88:89]
    v_pk_fma_f32 v[94:95], v[74:75], v[82:83], v[90:91]
    v_pk_fma_f32 v[96:97], v[40:41], v[84:85], v[12:13]
    v_pk_fma_f32 v[98:99], v[42:43], v[86:87], v[14:15]
    v_cvt_pk_bf16_f32 v96, v92, v96
    v_cvt_pk_bf16_f32 v97, v93, v97
    v_cvt_pk_bf16_f32 v98, v94, v98
    v_cvt_pk_bf16_f32 v99, v95, v99
    v_lshlrev_b32 v92, 16, v96
    v_lshlrev_b32 v93, 16, v97
    v_lshlrev_b32 v94, 16, v98
    v_lshlrev_b32 v95, 16, v99
    v_and_b32 v96, s20, v96
    v_and_b32 v97, s20, v97
    v_and_b32 v98, s20, v98
    v_and_b32 v99, s20, v99
    v_pk_add_f32 v[72:73], v[72:73], v[92:93]
    v_pk_add_f32 v[74:75], v[74:75], v[94:95]
    v_pk_add_f32 v[40:41], v[40:41], v[96:97]
    v_pk_add_f32 v[42:43], v[42:43], v[98:99]
    v_cvt_pk_bf16_f32 v40, v72, v40
    v_cvt_pk_bf16_f32 v41, v73, v41
    v_cvt_pk_bf16_f32 v42, v74, v42
    v_cvt_pk_bf16_f32 v43, v75, v43
    v_pk_fma_f32 v[92:93], v[76:77], v[80:81], v[88:89]
    v_pk_fma_f32 v[94:95], v[78:79], v[82:83], v[90:91]
    v_pk_fma_f32 v[96:97], v[44:45], v[84:85], v[12:13]
    v_pk_fma_f32 v[98:99], v[46:47], v[86:87], v[14:15]
    v_cvt_pk_bf16_f32 v96, v92, v96
    v_cvt_pk_bf16_f32 v97, v93, v97
    v_cvt_pk_bf16_f32 v98, v94, v98
    v_cvt_pk_bf16_f32 v99, v95, v99
    v_lshlrev_b32 v92, 16, v96
    v_lshlrev_b32 v93, 16, v97
    v_lshlrev_b32 v94, 16, v98
    v_lshlrev_b32 v95, 16, v99
    v_and_b32 v96, s20, v96
    v_and_b32 v97, s20, v97
    v_and_b32 v98, s20, v98
    v_and_b32 v99, s20, v99
    v_pk_add_f32 v[76:77], v[76:77], v[92:93]
    v_pk_add_f32 v[78:79], v[78:79], v[94:95]
    v_pk_add_f32 v[44:45], v[44:45], v[96:97]
    v_pk_add_f32 v[46:47], v[46:47], v[98:99]
    v_cvt_pk_bf16_f32 v44, v76, v44
    v_cvt_pk_bf16_f32 v45, v77, v45
    v_cvt_pk_bf16_f32 v46, v78, v46
    v_cvt_pk_bf16_f32 v47, v79, v47
    buffer_store_dwordx4 v[16:19], v4, s[16:19], 0 offen sc1
    buffer_store_dwordx4 v[20:23], v4, s[16:19], s25 offen sc1
    buffer_store_dwordx4 v[24:27], v4, s[16:19], s26 offen sc1
    buffer_store_dwordx4 v[28:31], v4, s[16:19], s27 offen sc1
    buffer_store_dwordx4 v[32:35], v4, s[16:19], s28 offen sc1
    buffer_store_dwordx4 v[36:39], v4, s[16:19], s29 offen sc1
    buffer_store_dwordx4 v[40:43], v4, s[16:19], s30 offen sc1
    buffer_store_dwordx4 v[44:47], v4, s[16:19], s31 offen sc1
L_end:
    s_endpgm
.section .rodata,"a"
.p2align 6
.amdhsa_kernel standalone__grn__sampling_kernel
  .amdhsa_next_free_vgpr 100
  .amdhsa_next_free_sgpr 32
  .amdhsa_accum_offset 100
  .amdhsa_group_segment_fixed_size 0
  .amdhsa_kernarg_size 48
  .amdhsa_user_sgpr_count 2
  .amdhsa_user_sgpr_kernarg_segment_ptr 1
  .amdhsa_system_sgpr_workgroup_id_x 1
  .amdhsa_float_denorm_mode_32 3
.end_amdhsa_kernel
```
